```python
import torch

def _softmax(x, axis=-1):
    return torch.softmax(x, dim=axis)
def _gelu(x):
    return torch.nn.functional.gelu(x, approximate="tanh")
def _silu(x):
    return torch.nn.functional.silu(x)
def _sigmoid(x):
    return torch.sigmoid(x)
def _layernorm(x, axis=-1, eps=1e-5):
    m = x.mean(dim=axis, keepdim=True)
    v = x.var(dim=axis, keepdim=True, unbiased=False)
    return (x - m) / torch.sqrt(v + eps)
def _scatter_add(tgt, idx, src, axis=0):
    return tgt.clone().index_add_(axis, idx, src)
def _segment_sum(src, seg, n):
    out = torch.zeros((n,) + src.shape[1:], dtype=src.dtype)
    return out.index_add_(0, seg, src)
def _pad(x, pw):
    flat = tuple(v for pair in reversed(pw) for v in pair)
    return torch.nn.functional.pad(x, flat)

kernel_name = 'standalone__sliding_block_cached__decode'

def setup_inputs():

    _w = (lambda a: (lambda t: t.to(torch.bfloat16) if t.is_floating_point() else t)(torch.as_tensor(a)))
    B, Sq, D = 1, 1, 640
    Hq, Hkv, Sk, Dh = 32, 32, 32768, 192
    assert Hq % Hkv == 0, (Hq, Hkv)
    return {
        "x": _w((lambda *s: torch.randn(*s, dtype=torch.bfloat16) * 0.8)(B, Sq, D)),
        "k_cache": _w((lambda *s: torch.randn(*s, dtype=torch.bfloat16) * 0.8)(B, Hkv, Sk, Dh)),
        "v_cache": _w((lambda *s: torch.randn(*s, dtype=torch.bfloat16) * 0.05)(B, Hkv, Sk, Dh)),
        "wq": _w((lambda *s: torch.randn(*s, dtype=torch.bfloat16) * 0.8)(D, Hq * Dh) * (D ** -0.5)),
        "wo": _w((lambda *s: torch.randn(*s, dtype=torch.bfloat16) * 0.05)(Hq * Dh, D) * ((Hq * Dh) ** -0.5)),
    }

def reference(x, k_cache, v_cache, wq, wo):
    B, Sq, D = x.shape
    Hq, Dh = 32, 192
    Hkv, Sk = k_cache.shape[1], k_cache.shape[2]
    W = min(4096, max(256, Sk // 4))
    rep = Hq // Hkv
    q = (lambda x, *d: x.permute(*d))((x @ wq).reshape(B, Sq, Hq, Dh), 0, 2, 1, 3)
    k = (lambda x, n, axis: torch.repeat_interleave(x, n, dim=axis))(k_cache[:, :, Sk - W:, :], rep, axis=1)
    v = (lambda x, n, axis: torch.repeat_interleave(x, n, dim=axis))(v_cache[:, :, Sk - W:, :], rep, axis=1)
    scores = torch.einsum("bhqd,bhkd->bhqk", q, k) * (Dh ** -0.5)
    p = _softmax(scores, axis=-1)
    o = torch.einsum("bhqk,bhkd->bhqd", p, v)
    return (lambda x, *d: x.permute(*d))(o, 0, 2, 1, 3).reshape(B, Sq, Hq * Dh) @ wo
```

```asm
; @launch grid=(256,1,1) block=(512,1,1) lds=17920
.amdgcn_target "amdgcn-amd-amdhsa--gfx950"
.text
.globl standalone__sliding_block_cached__decode_kernel
.p2align 8
.type standalone__sliding_block_cached__decode_kernel,@function
standalone__sliding_block_cached__decode_kernel:
    s_cmpk_ge_u32 s2, 0x100
    s_cbranch_scc1 L_end
    s_load_dwordx16 s[8:23], s[0:1], 0
    s_memrealtime s[96:97]
    v_readfirstlane_b32 s26, v0
    s_and_b32 s27, s2, 7
    s_lshr_b32 s24, s2, 6
    s_lshl3_add_u32 s30, s24, s27
    s_lshr_b32 s28, s2, 3
    s_and_b32 s25, s28, 7
    v_lshrrev_b32 v2, 3, v0
    v_lshlrev_b32 v1, 4, v0
    s_lshl_b32 s46, s30, 12
    s_mul_i32 s47, s25, 7
    s_add_u32 s46, s46, s47
    s_addk_i32 s46, 3583
    s_mulk_i32 s46, 3072
    v_lshl_add_u32 v1, v2, 8, v1
    v_add_u32 v1, s46, v1
    s_cmp_eq_u32 s26, 0
    s_cbranch_scc1 L_qwave
    s_waitcnt lgkmcnt(0)
    global_load_dwordx4 v[40:43], v1, s[10:11] offset:0 nt
    global_load_dwordx4 v[44:47], v1, s[10:11] offset:128 nt
    global_load_dwordx4 v[48:51], v1, s[10:11] offset:256 nt
    s_mov_b32 s29, 172032
    s_add_u32 s10, s10, s29
    s_addc_u32 s11, s11, 0
    global_load_dwordx4 v[52:55], v1, s[10:11] offset:0 nt
    global_load_dwordx4 v[56:59], v1, s[10:11] offset:128 nt
    global_load_dwordx4 v[60:63], v1, s[10:11] offset:256 nt
    s_add_u32 s10, s10, s29
    s_addc_u32 s11, s11, 0
    s_lshr_b32 s26, s26, 6
    s_lshl2_add_u32 s24, s27, s24
    v_and_b32 v0, 63, v0
    v_and_b32 v2, 7, v2
    v_and_b32 v3, 7, v0
    v_mov_b32 v4, 0
    s_barrier
    s_waitcnt vmcnt(2)
    global_load_dwordx4 v[64:67], v1, s[10:11] offset:0 nt
    global_load_dwordx4 v[68:71], v1, s[10:11] offset:128 nt
    global_load_dwordx4 v[72:75], v1, s[10:11] offset:256 nt
    s_add_u32 s10, s10, s29
    s_addc_u32 s11, s11, 0
    s_waitcnt vmcnt(8)
L_acc3:
    s_memrealtime s[98:99]
    s_getreg_b32 s100, hwreg(HW_REG_IB_STS, 0, 4)
    s_cmp_le_u32 s100, 2
    s_cbranch_scc1 L_go3
    s_waitcnt lgkmcnt(0)
    s_sub_u32 s98, s98, s96
    s_cmp_lt_u32 s98, 446
    s_cbranch_scc1 L_acc3
L_go3:
    global_load_dwordx4 v[76:79], v1, s[10:11] offset:0 nt
    global_load_dwordx4 v[80:83], v1, s[10:11] offset:128 nt
    global_load_dwordx4 v[84:87], v1, s[10:11] offset:256 nt
    s_add_u32 s10, s10, s29
    s_addc_u32 s11, s11, 0
    s_waitcnt vmcnt(8)
L_acc4:
    s_memrealtime s[98:99]
    s_getreg_b32 s100, hwreg(HW_REG_IB_STS, 0, 4)
    s_cmp_le_u32 s100, 2
    s_cbranch_scc1 L_go4
    s_waitcnt lgkmcnt(0)
    s_sub_u32 s98, s98, s96
    s_cmp_lt_u32 s98, 522
    s_cbranch_scc1 L_acc4
L_go4:
    global_load_dwordx4 v[88:91], v1, s[10:11] offset:0 nt
    global_load_dwordx4 v[92:95], v1, s[10:11] offset:128 nt
    global_load_dwordx4 v[96:99], v1, s[10:11] offset:256 nt
    s_add_u32 s10, s10, s29
    s_addc_u32 s11, s11, 0
    s_waitcnt vmcnt(8)
L_acc5:
    s_memrealtime s[98:99]
    s_getreg_b32 s100, hwreg(HW_REG_IB_STS, 0, 4)
    s_cmp_le_u32 s100, 2
    s_cbranch_scc1 L_go5
    s_waitcnt lgkmcnt(0)
    s_sub_u32 s98, s98, s96
    s_cmp_lt_u32 s98, 598
    s_cbranch_scc1 L_acc5
L_go5:
    global_load_dwordx4 v[100:103], v1, s[10:11] offset:0 nt
    global_load_dwordx4 v[104:107], v1, s[10:11] offset:128 nt
    global_load_dwordx4 v[108:111], v1, s[10:11] offset:256 nt
    s_add_u32 s10, s10, s29
    s_addc_u32 s11, s11, 0
    s_waitcnt vmcnt(8)
L_acc6:
    s_memrealtime s[98:99]
    s_getreg_b32 s100, hwreg(HW_REG_IB_STS, 0, 4)
    s_cmp_le_u32 s100, 2
    s_cbranch_scc1 L_go6
    s_waitcnt lgkmcnt(0)
    s_sub_u32 s98, s98, s96
    s_cmp_lt_u32 s98, 674
    s_cbranch_scc1 L_acc6
L_go6:
    global_load_dwordx4 v[112:115], v1, s[10:11] offset:0 nt
    global_load_dwordx4 v[116:119], v1, s[10:11] offset:128 nt
    global_load_dwordx4 v[120:123], v1, s[10:11] offset:256 nt
    s_add_u32 s10, s10, s29
    s_addc_u32 s11, s11, 0
    s_waitcnt vmcnt(8)
L_acc7:
    s_memrealtime s[98:99]
    s_getreg_b32 s100, hwreg(HW_REG_IB_STS, 0, 4)
    s_cmp_le_u32 s100, 2
    s_cbranch_scc1 L_go7
    s_waitcnt lgkmcnt(0)
    s_sub_u32 s98, s98, s96
    s_cmp_lt_u32 s98, 750
    s_cbranch_scc1 L_acc7
L_go7:
    global_load_dwordx4 v[124:127], v1, s[10:11] offset:0 nt
    global_load_dwordx4 v[128:131], v1, s[10:11] offset:128 nt
    global_load_dwordx4 v[132:135], v1, s[10:11] offset:256 nt
    s_add_u32 s10, s10, s29
    s_addc_u32 s11, s11, 0
    s_waitcnt vmcnt(8)
L_acc8:
    s_memrealtime s[98:99]
    s_getreg_b32 s100, hwreg(HW_REG_IB_STS, 0, 4)
    s_cmp_le_u32 s100, 2
    s_cbranch_scc1 L_go8
    s_waitcnt lgkmcnt(0)
    s_sub_u32 s98, s98, s96
    s_cmp_lt_u32 s98, 826
    s_cbranch_scc1 L_acc8
L_go8:
    global_load_dwordx4 v[136:139], v1, s[10:11] offset:0 nt
    global_load_dwordx4 v[140:143], v1, s[10:11] offset:128 nt
    global_load_dwordx4 v[144:147], v1, s[10:11] offset:256 nt
    s_nop 0
    s_branch L_scont
L_qwave:
    s_setprio 3
    s_lshl2_add_u32 s24, s27, s24
    v_mov_b32 v4, 0
    v_and_b32 v3, 7, v0
    s_mul_i32 s47, s25, 6
    s_sub_u32 s47, 505, s47
    s_mul_i32 s47, s47, 3072
    v_add_u32 v1, s47, v1
    v_mov_b32 v5, 0
    v_mov_b32 v6, 0
    v_mov_b32 v7, 0
    ds_write_b128 v4, v[4:7] offset:0
    v_mul_u32_u24 v8, 20, v2
    s_mul_i32 s47, s25, 160
    v_add_u32 v8, s47, v8
    v_mul_u32_u24 v160, 122880, v2
    v_lshl_add_u32 v160, v3, 4, v160
    s_mul_i32 s47, s25, 983040
    s_mul_i32 s48, s30, 384
    s_add_u32 s47, s47, s48
    v_add_u32 v160, s47, v160
    v_add_u32 v161, 12288, v160
    v_add_u32 v162, 24576, v160
    v_add_u32 v163, 36864, v160
    v_add_u32 v164, 49152, v160
    v_add_u32 v165, 61440, v160
    v_add_u32 v166, 73728, v160
    v_add_u32 v167, 86016, v160
    v_add_u32 v168, 98304, v160
    v_add_u32 v169, 110592, v160
    s_waitcnt lgkmcnt(0)
    s_barrier
    s_load_dwordx2 s[4:5], s[22:23], 0
    global_load_dwordx4 v[28:31], v8, s[8:9] nt
    global_load_dword v32, v8, s[8:9] offset:16 nt
    global_load_dwordx4 v[40:43], v160, s[14:15] offset:0 nt
    global_load_dwordx4 v[44:47], v160, s[14:15] offset:128 nt
    global_load_dwordx4 v[48:51], v160, s[14:15] offset:256 nt
    global_load_dwordx4 v[52:55], v161, s[14:15] offset:0 nt
    global_load_dwordx4 v[56:59], v161, s[14:15] offset:128 nt
    global_load_dwordx4 v[60:63], v161, s[14:15] offset:256 nt
    global_load_dwordx4 v[64:67], v162, s[14:15] offset:0 nt
    global_load_dwordx4 v[68:71], v162, s[14:15] offset:128 nt
    global_load_dwordx4 v[72:75], v162, s[14:15] offset:256 nt
    global_load_dwordx4 v[76:79], v163, s[14:15] offset:0 nt
    global_load_dwordx4 v[80:83], v163, s[14:15] offset:128 nt
    global_load_dwordx4 v[84:87], v163, s[14:15] offset:256 nt
    global_load_dwordx4 v[88:91], v164, s[14:15] offset:0 nt
    global_load_dwordx4 v[92:95], v164, s[14:15] offset:128 nt
    global_load_dwordx4 v[96:99], v164, s[14:15] offset:256 nt
    global_load_dwordx4 v[100:103], v165, s[14:15] offset:0 nt
    global_load_dwordx4 v[104:107], v165, s[14:15] offset:128 nt
    global_load_dwordx4 v[108:111], v165, s[14:15] offset:256 nt
    global_load_dwordx4 v[112:115], v166, s[14:15] offset:0 nt
    global_load_dwordx4 v[116:119], v166, s[14:15] offset:128 nt
    global_load_dwordx4 v[120:123], v166, s[14:15] offset:256 nt
    global_load_dwordx4 v[124:127], v167, s[14:15] offset:0 nt
    global_load_dwordx4 v[128:131], v167, s[14:15] offset:128 nt
    global_load_dwordx4 v[132:135], v167, s[14:15] offset:256 nt
    global_load_dwordx4 v[136:139], v168, s[14:15] offset:0 nt
    global_load_dwordx4 v[140:143], v168, s[14:15] offset:128 nt
    global_load_dwordx4 v[144:147], v168, s[14:15] offset:256 nt
    global_load_dwordx4 v[148:151], v169, s[14:15] offset:0 nt
    global_load_dwordx4 v[152:155], v169, s[14:15] offset:128 nt
    global_load_dwordx4 v[156:159], v169, s[14:15] offset:256 nt
    global_load_dwordx4 v[232:235], v1, s[10:11] offset:0 nt
    global_load_dwordx4 v[236:239], v1, s[10:11] offset:128 nt
    global_load_dwordx4 v[240:243], v1, s[10:11] offset:256 nt
    global_load_dwordx4 v[244:247], v1, s[12:13] offset:0 nt
    global_load_dwordx4 v[248:251], v1, s[12:13] offset:128 nt
    global_load_dwordx4 v[252:255], v1, s[12:13] offset:256 nt
    s_branch L_qcont
L_scont:
    s_waitcnt vmcnt(8)
L_acc9:
    s_memrealtime s[98:99]
    s_getreg_b32 s100, hwreg(HW_REG_IB_STS, 0, 4)
    s_cmp_le_u32 s100, 2
    s_cbranch_scc1 L_go9
    s_waitcnt lgkmcnt(0)
    s_sub_u32 s98, s98, s96
    s_cmp_lt_u32 s98, 902
    s_cbranch_scc1 L_acc9
L_go9:
    global_load_dwordx4 v[148:151], v1, s[12:13] offset:0 nt
    global_load_dwordx4 v[152:155], v1, s[12:13] offset:128 nt
    global_load_dwordx4 v[156:159], v1, s[12:13] offset:256 nt
    s_add_u32 s12, s12, s29
    s_addc_u32 s13, s13, 0
    s_waitcnt vmcnt(8)
L_acc10:
    s_memrealtime s[98:99]
    s_getreg_b32 s100, hwreg(HW_REG_IB_STS, 0, 4)
    s_cmp_le_u32 s100, 2
    s_cbranch_scc1 L_go10
    s_waitcnt lgkmcnt(0)
    s_sub_u32 s98, s98, s96
    s_cmp_lt_u32 s98, 978
    s_cbranch_scc1 L_acc10
L_go10:
    global_load_dwordx4 v[160:163], v1, s[12:13] offset:0 nt
    global_load_dwordx4 v[164:167], v1, s[12:13] offset:128 nt
    global_load_dwordx4 v[168:171], v1, s[12:13] offset:256 nt
    s_add_u32 s12, s12, s29
    s_addc_u32 s13, s13, 0
    s_waitcnt vmcnt(8)
L_acc11:
    s_memrealtime s[98:99]
    s_getreg_b32 s100, hwreg(HW_REG_IB_STS, 0, 4)
    s_cmp_le_u32 s100, 2
    s_cbranch_scc1 L_go11
    s_waitcnt lgkmcnt(0)
    s_sub_u32 s98, s98, s96
    s_cmp_lt_u32 s98, 1054
    s_cbranch_scc1 L_acc11
L_go11:
    global_load_dwordx4 v[172:175], v1, s[12:13] offset:0 nt
    global_load_dwordx4 v[176:179], v1, s[12:13] offset:128 nt
    global_load_dwordx4 v[180:183], v1, s[12:13] offset:256 nt
    s_add_u32 s12, s12, s29
    s_addc_u32 s13, s13, 0
    v_and_b32 v5, 1, v0
    v_lshlrev_b32 v5, 4, v5
    v_mov_b32 v6, 0xffff
    v_lshlrev_b32 v6, v5, v6
    v_lshrrev_b32 v5, 1, v3
    v_cmp_eq_u32 vcc, 0, v5
    s_nop 1
    v_cndmask_b32 v12, 0, v6, vcc
    v_cmp_eq_u32 vcc, 1, v5
    s_nop 1
    v_cndmask_b32 v13, 0, v6, vcc
    v_cmp_eq_u32 vcc, 2, v5
    s_nop 1
    v_cndmask_b32 v14, 0, v6, vcc
    v_cmp_eq_u32 vcc, 3, v5
    s_nop 1
    v_cndmask_b32 v15, 0, v6, vcc
    v_lshrrev_b32 v5, 5, v0
    v_mul_u32_u24 v8, 768, v5
    v_lshl_add_u32 v8, v3, 5, v8
    v_and_b32 v5, 16, v0
    v_add_u32 v8, v8, v5
    v_lshrrev_b32 v9, 5, v0
    v_lshrrev_b32 v5, 1, v5
    v_add_u32 v9, v9, v5
    v_mul_u32_u24 v9, 1280, v9
    v_and_b32 v5, 15, v0
    v_lshl_add_u32 v9, v5, 4, v9
    s_mul_i32 s50, s28, 13108
    s_lshr_b32 s50, s50, 16
    s_mul_i32 s51, s50, 5
    s_sub_u32 s51, s28, s51
    s_lshl3_add_u32 s52, s24, s25
    s_mul_i32 s53, s51, 4096
    s_lshl_b32 s47, s51, 8
    s_add_u32 s18, s18, s47
    s_addc_u32 s19, s19, 0
    s_add_u32 s53, s53, 1048576
    s_mul_i32 s47, s52, 1536
    s_add_u32 s47, s47, 524288
    s_add_u32 s54, s22, s47
    s_addc_u32 s55, s23, 0
    s_add_u32 s56, s22, s53
    s_addc_u32 s57, s23, 0
    s_mov_b32 s44, 16711935
    s_mov_b32 s45, 4278255360
    s_mul_i32 s58, s27, 768
    s_lshl_b32 s47, s50, 7
    s_add_u32 s58, s58, s47
    s_lshl_b32 s47, s26, 4
    s_add_u32 s58, s58, s47
    s_cmp_ge_u32 s28, 30
    s_cselect_b32 s58, 0, s58
    s_cselect_b32 s51, 0, s51
    s_lshr_b32 s47, s58, 6
    s_mul_i32 s59, s47, 43691
    s_lshr_b32 s59, s59, 17
    s_mul_i32 s47, s59, 192
    s_sub_u32 s58, s58, s47
    s_and_b32 s47, s59, 3
    s_lshr_b32 s46, s59, 2
    s_lshl3_add_u32 s47, s47, s46
    s_mul_i32 s47, s47, 192
    s_add_u32 s47, s47, s58
    s_mul_i32 s47, s47, 1280
    s_lshl_b32 s46, s51, 8
    s_add_u32 s47, s47, s46
    s_add_u32 s47, s47, 3840
    s_add_u32 s60, s16, s47
    s_addc_u32 s61, s17, 0
    s_mul_i32 s47, s59, 12288
    s_lshl_b32 s46, s58, 3
    s_add_u32 s47, s47, s46
    s_add_u32 s47, s47, 527360
    s_add_u32 s50, s22, s47
    s_addc_u32 s51, s23, 0
    s_mov_b32 s6, 1033096506
    s_mov_b32 s7, 1069066811
    s_mov_b32 s49, 262144
L_qwait:
    ds_read_b32 v5, v4 offset:0
    s_waitcnt lgkmcnt(0)
    v_readfirstlane_b32 s47, v5
    s_cmp_lg_u32 s47, 0
    s_cbranch_scc1 L_qready
    s_sleep 2
    s_sub_u32 s49, s49, 1
    s_cbranch_scc0 L_qwait
    s_branch L_end
L_qready:
    v_lshlrev_b32 v5, 4, v3
    ds_read_b64 v[10:11], v4 offset:16
    ds_read_b128 v[16:19], v5 offset:128
    ds_read_b128 v[20:23], v5 offset:256
    ds_read_b128 v[24:27], v5 offset:384
    s_waitcnt lgkmcnt(0)
    v_readfirstlane_b32 s4, v10
    v_readfirstlane_b32 s5, v11
    s_waitcnt vmcnt(8)
L_acc12:
    s_memrealtime s[98:99]
    s_getreg_b32 s100, hwreg(HW_REG_IB_STS, 0, 4)
    s_cmp_le_u32 s100, 2
    s_cbranch_scc1 L_go12
    s_waitcnt lgkmcnt(0)
    s_sub_u32 s98, s98, s96
    s_cmp_lt_u32 s98, 1130
    s_cbranch_scc1 L_acc12
L_go12:
    global_load_dwordx4 v[184:187], v1, s[12:13] offset:0 nt
    global_load_dwordx4 v[188:191], v1, s[12:13] offset:128 nt
    global_load_dwordx4 v[192:195], v1, s[12:13] offset:256 nt
    s_add_u32 s12, s12, s29
    s_addc_u32 s13, s13, 0
    s_waitcnt vmcnt(36)
    v_dot2_f32_bf16 v28, v40, v16, 0
    v_dot2_f32_bf16 v28, v41, v17, v28
    v_dot2_f32_bf16 v28, v42, v18, v28
    v_dot2_f32_bf16 v28, v43, v19, v28
    v_dot2_f32_bf16 v28, v44, v20, v28
    v_dot2_f32_bf16 v28, v45, v21, v28
    v_dot2_f32_bf16 v28, v46, v22, v28
    v_dot2_f32_bf16 v28, v47, v23, v28
    v_dot2_f32_bf16 v28, v48, v24, v28
    v_dot2_f32_bf16 v28, v49, v25, v28
    v_dot2_f32_bf16 v28, v50, v26, v28
    v_dot2_f32_bf16 v28, v51, v27, v28
    s_waitcnt vmcnt(33)
    v_dot2_f32_bf16 v29, v52, v16, 0
    v_dot2_f32_bf16 v29, v53, v17, v29
    v_dot2_f32_bf16 v29, v54, v18, v29
    v_dot2_f32_bf16 v29, v55, v19, v29
    v_dot2_f32_bf16 v29, v56, v20, v29
    v_dot2_f32_bf16 v29, v57, v21, v29
    v_dot2_f32_bf16 v29, v58, v22, v29
    v_dot2_f32_bf16 v29, v59, v23, v29
    v_dot2_f32_bf16 v29, v60, v24, v29
    v_dot2_f32_bf16 v29, v61, v25, v29
    v_dot2_f32_bf16 v29, v62, v26, v29
    v_dot2_f32_bf16 v29, v63, v27, v29
    s_waitcnt vmcnt(30)
    v_dot2_f32_bf16 v30, v64, v16, 0
    v_dot2_f32_bf16 v30, v65, v17, v30
    v_dot2_f32_bf16 v30, v66, v18, v30
    v_dot2_f32_bf16 v30, v67, v19, v30
    v_dot2_f32_bf16 v30, v68, v20, v30
    v_dot2_f32_bf16 v30, v69, v21, v30
    v_dot2_f32_bf16 v30, v70, v22, v30
    v_dot2_f32_bf16 v30, v71, v23, v30
    v_dot2_f32_bf16 v30, v72, v24, v30
    v_dot2_f32_bf16 v30, v73, v25, v30
    v_dot2_f32_bf16 v30, v74, v26, v30
    v_dot2_f32_bf16 v30, v75, v27, v30
    s_waitcnt vmcnt(27)
    v_dot2_f32_bf16 v31, v76, v16, 0
    v_dot2_f32_bf16 v31, v77, v17, v31
    v_dot2_f32_bf16 v31, v78, v18, v31
    v_dot2_f32_bf16 v31, v79, v19, v31
    v_dot2_f32_bf16 v31, v80, v20, v31
    v_dot2_f32_bf16 v31, v81, v21, v31
    v_dot2_f32_bf16 v31, v82, v22, v31
    v_dot2_f32_bf16 v31, v83, v23, v31
    v_dot2_f32_bf16 v31, v84, v24, v31
    v_dot2_f32_bf16 v31, v85, v25, v31
    v_dot2_f32_bf16 v31, v86, v26, v31
    v_dot2_f32_bf16 v31, v87, v27, v31
    s_waitcnt vmcnt(24)
    v_dot2_f32_bf16 v32, v88, v16, 0
    v_dot2_f32_bf16 v32, v89, v17, v32
    v_dot2_f32_bf16 v32, v90, v18, v32
    v_dot2_f32_bf16 v32, v91, v19, v32
    v_dot2_f32_bf16 v32, v92, v20, v32
    v_dot2_f32_bf16 v32, v93, v21, v32
    v_dot2_f32_bf16 v32, v94, v22, v32
    v_dot2_f32_bf16 v32, v95, v23, v32
    v_dot2_f32_bf16 v32, v96, v24, v32
    v_dot2_f32_bf16 v32, v97, v25, v32
    v_dot2_f32_bf16 v32, v98, v26, v32
    v_dot2_f32_bf16 v32, v99, v27, v32
    s_waitcnt vmcnt(8)
L_acc13:
    s_memrealtime s[98:99]
    s_getreg_b32 s100, hwreg(HW_REG_IB_STS, 0, 4)
    s_cmp_le_u32 s100, 2
    s_cbranch_scc1 L_go13
    s_waitcnt lgkmcnt(0)
    s_sub_u32 s98, s98, s96
    s_cmp_lt_u32 s98, 1206
    s_cbranch_scc1 L_acc13
L_go13:
    global_load_dwordx4 v[196:199], v1, s[12:13] offset:0 nt
    global_load_dwordx4 v[200:203], v1, s[12:13] offset:128 nt
    global_load_dwordx4 v[204:207], v1, s[12:13] offset:256 nt
    s_add_u32 s12, s12, s29
    s_addc_u32 s13, s13, 0
    s_waitcnt vmcnt(24)
    v_dot2_f32_bf16 v33, v100, v16, 0
    v_dot2_f32_bf16 v33, v101, v17, v33
    v_dot2_f32_bf16 v33, v102, v18, v33
    v_dot2_f32_bf16 v33, v103, v19, v33
    v_dot2_f32_bf16 v33, v104, v20, v33
    v_dot2_f32_bf16 v33, v105, v21, v33
    v_dot2_f32_bf16 v33, v106, v22, v33
    v_dot2_f32_bf16 v33, v107, v23, v33
    v_dot2_f32_bf16 v33, v108, v24, v33
    v_dot2_f32_bf16 v33, v109, v25, v33
    v_dot2_f32_bf16 v33, v110, v26, v33
    v_dot2_f32_bf16 v33, v111, v27, v33
    s_waitcnt vmcnt(21)
    v_dot2_f32_bf16 v34, v112, v16, 0
    v_dot2_f32_bf16 v34, v113, v17, v34
    v_dot2_f32_bf16 v34, v114, v18, v34
    v_dot2_f32_bf16 v34, v115, v19, v34
    v_dot2_f32_bf16 v34, v116, v20, v34
    v_dot2_f32_bf16 v34, v117, v21, v34
    v_dot2_f32_bf16 v34, v118, v22, v34
    v_dot2_f32_bf16 v34, v119, v23, v34
    v_dot2_f32_bf16 v34, v120, v24, v34
    v_dot2_f32_bf16 v34, v121, v25, v34
    v_dot2_f32_bf16 v34, v122, v26, v34
    v_dot2_f32_bf16 v34, v123, v27, v34
    s_waitcnt vmcnt(18)
    v_dot2_f32_bf16 v35, v124, v16, 0
    v_dot2_f32_bf16 v35, v125, v17, v35
    v_dot2_f32_bf16 v35, v126, v18, v35
    v_dot2_f32_bf16 v35, v127, v19, v35
    v_dot2_f32_bf16 v35, v128, v20, v35
    v_dot2_f32_bf16 v35, v129, v21, v35
    v_dot2_f32_bf16 v35, v130, v22, v35
    v_dot2_f32_bf16 v35, v131, v23, v35
    v_dot2_f32_bf16 v35, v132, v24, v35
    v_dot2_f32_bf16 v35, v133, v25, v35
    v_dot2_f32_bf16 v35, v134, v26, v35
    v_dot2_f32_bf16 v35, v135, v27, v35
    s_waitcnt vmcnt(15)
    v_dot2_f32_bf16 v36, v136, v16, 0
    v_dot2_f32_bf16 v36, v137, v17, v36
    v_dot2_f32_bf16 v36, v138, v18, v36
    v_dot2_f32_bf16 v36, v139, v19, v36
    v_dot2_f32_bf16 v36, v140, v20, v36
    v_dot2_f32_bf16 v36, v141, v21, v36
    v_dot2_f32_bf16 v36, v142, v22, v36
    v_dot2_f32_bf16 v36, v143, v23, v36
    v_dot2_f32_bf16 v36, v144, v24, v36
    v_dot2_f32_bf16 v36, v145, v25, v36
    v_dot2_f32_bf16 v36, v146, v26, v36
    v_dot2_f32_bf16 v36, v147, v27, v36
    v_mov_b32 v16, 0
    v_mov_b32 v17, 0
    v_mov_b32 v18, 0
    v_mov_b32 v19, 0
    v_mov_b32 v20, 0
    v_mov_b32 v21, 0
    v_mov_b32 v22, 0
    v_mov_b32 v23, 0
    v_mov_b32 v24, 0
    v_mov_b32 v25, 0
    v_mov_b32 v26, 0
    v_mov_b32 v27, 0
    v_add_f32_dpp v28, v28, v28 quad_perm:[1,0,3,2] row_mask:0xf bank_mask:0xf
    v_add_f32_dpp v29, v29, v29 quad_perm:[1,0,3,2] row_mask:0xf bank_mask:0xf
    v_add_f32_dpp v30, v30, v30 quad_perm:[1,0,3,2] row_mask:0xf bank_mask:0xf
    v_add_f32_dpp v31, v31, v31 quad_perm:[1,0,3,2] row_mask:0xf bank_mask:0xf
    v_add_f32_dpp v32, v32, v32 quad_perm:[1,0,3,2] row_mask:0xf bank_mask:0xf
    v_add_f32_dpp v33, v33, v33 quad_perm:[1,0,3,2] row_mask:0xf bank_mask:0xf
    v_add_f32_dpp v34, v34, v34 quad_perm:[1,0,3,2] row_mask:0xf bank_mask:0xf
    v_add_f32_dpp v35, v35, v35 quad_perm:[1,0,3,2] row_mask:0xf bank_mask:0xf
    v_add_f32_dpp v36, v36, v36 quad_perm:[1,0,3,2] row_mask:0xf bank_mask:0xf
    v_add_f32_dpp v28, v28, v28 quad_perm:[2,3,0,1] row_mask:0xf bank_mask:0xf
    v_add_f32_dpp v29, v29, v29 quad_perm:[2,3,0,1] row_mask:0xf bank_mask:0xf
    v_add_f32_dpp v30, v30, v30 quad_perm:[2,3,0,1] row_mask:0xf bank_mask:0xf
    v_add_f32_dpp v31, v31, v31 quad_perm:[2,3,0,1] row_mask:0xf bank_mask:0xf
    v_add_f32_dpp v32, v32, v32 quad_perm:[2,3,0,1] row_mask:0xf bank_mask:0xf
    v_add_f32_dpp v33, v33, v33 quad_perm:[2,3,0,1] row_mask:0xf bank_mask:0xf
    v_add_f32_dpp v34, v34, v34 quad_perm:[2,3,0,1] row_mask:0xf bank_mask:0xf
    v_add_f32_dpp v35, v35, v35 quad_perm:[2,3,0,1] row_mask:0xf bank_mask:0xf
    v_add_f32_dpp v36, v36, v36 quad_perm:[2,3,0,1] row_mask:0xf bank_mask:0xf
    v_add_f32_dpp v28, v28, v28 row_half_mirror row_mask:0xf bank_mask:0xf
    v_add_f32_dpp v29, v29, v29 row_half_mirror row_mask:0xf bank_mask:0xf
    v_add_f32_dpp v30, v30, v30 row_half_mirror row_mask:0xf bank_mask:0xf
    v_add_f32_dpp v31, v31, v31 row_half_mirror row_mask:0xf bank_mask:0xf
    v_add_f32_dpp v32, v32, v32 row_half_mirror row_mask:0xf bank_mask:0xf
    v_add_f32_dpp v33, v33, v33 row_half_mirror row_mask:0xf bank_mask:0xf
    v_add_f32_dpp v34, v34, v34 row_half_mirror row_mask:0xf bank_mask:0xf
    v_add_f32_dpp v35, v35, v35 row_half_mirror row_mask:0xf bank_mask:0xf
    v_add_f32_dpp v36, v36, v36 row_half_mirror row_mask:0xf bank_mask:0xf
    v_cvt_pk_bf16_f32 v96, v28, v29
    v_cvt_pk_bf16_f32 v97, v30, v31
    v_cvt_pk_bf16_f32 v98, v32, v33
    v_cvt_pk_bf16_f32 v99, v34, v35
    v_cvt_pk_bf16_f32 v100, v36, v36
    v_lshlrev_b32 v28, 16, v96
    v_and_b32 v29, 0xffff0000, v96
    v_lshlrev_b32 v30, 16, v97
    v_and_b32 v31, 0xffff0000, v97
    v_lshlrev_b32 v32, 16, v98
    v_and_b32 v33, 0xffff0000, v98
    v_lshlrev_b32 v34, 16, v99
    v_and_b32 v35, 0xffff0000, v99
    v_lshlrev_b32 v36, 16, v100
    v_mul_f32 v28, s6, v28
    v_mul_f32 v29, s6, v29
    v_mul_f32 v30, s6, v30
    v_mul_f32 v31, s6, v31
    v_mul_f32 v32, s6, v32
    v_mul_f32 v33, s6, v33
    v_mul_f32 v34, s6, v34
    v_mul_f32 v35, s6, v35
    v_mul_f32 v36, s6, v36
    v_cvt_pk_bf16_f32 v96, v28, v29
    v_cvt_pk_bf16_f32 v97, v30, v31
    v_cvt_pk_bf16_f32 v98, v32, v33
    v_cvt_pk_bf16_f32 v99, v34, v35
    v_cvt_pk_bf16_f32 v100, v36, v36
    v_lshlrev_b32 v28, 16, v96
    v_and_b32 v29, 0xffff0000, v96
    v_lshlrev_b32 v30, 16, v97
    v_and_b32 v31, 0xffff0000, v97
    v_lshlrev_b32 v32, 16, v98
    v_and_b32 v33, 0xffff0000, v98
    v_lshlrev_b32 v34, 16, v99
    v_and_b32 v35, 0xffff0000, v99
    v_lshlrev_b32 v36, 16, v100
    v_max3_f32 v10, v28, v29, v30
    v_max3_f32 v10, v10, v31, v32
    v_max3_f32 v10, v10, v33, v34
    v_max3_f32 v10, v10, v35, v36
    s_nop 1
    v_max_f32_dpp v10, v10, v10 row_ror:8 row_mask:0xf bank_mask:0xf
    v_mov_b32 v96, v10
    s_nop 1
    v_permlane16_swap_b32 v10, v96
    v_max_f32 v10, v10, v96
    v_mov_b32 v96, v10
    s_nop 1
    v_permlane32_swap_b32 v10, v96
    v_max_f32 v10, v10, v96
    s_mov_b32 s47, 1101004800
    v_cmp_lt_f32 vcc, s47, |v10|
    s_nop 1
    v_cndmask_b32 v10, 0, v10, vcc
    v_sub_f32 v28, v28, v10
    v_sub_f32 v29, v29, v10
    v_sub_f32 v30, v30, v10
    v_sub_f32 v31, v31, v10
    v_sub_f32 v32, v32, v10
    v_sub_f32 v33, v33, v10
    v_sub_f32 v34, v34, v10
    v_sub_f32 v35, v35, v10
    v_sub_f32 v36, v36, v10
    v_mul_f32 v28, s7, v28
    v_mul_f32 v29, s7, v29
    v_mul_f32 v30, s7, v30
    v_mul_f32 v31, s7, v31
    v_mul_f32 v32, s7, v32
    v_mul_f32 v33, s7, v33
    v_mul_f32 v34, s7, v34
    v_mul_f32 v35, s7, v35
    v_mul_f32 v36, s7, v36
    v_exp_f32 v28, v28
    v_exp_f32 v29, v29
    v_exp_f32 v30, v30
    v_exp_f32 v31, v31
    v_exp_f32 v32, v32
    v_exp_f32 v33, v33
    v_exp_f32 v34, v34
    v_exp_f32 v35, v35
    v_exp_f32 v36, v36
    s_waitcnt vmcnt(8)
L_acc14:
    s_memrealtime s[98:99]
    s_getreg_b32 s100, hwreg(HW_REG_IB_STS, 0, 4)
    s_cmp_le_u32 s100, 2
    s_cbranch_scc1 L_go14
    s_waitcnt lgkmcnt(0)
    s_sub_u32 s98, s98, s96
    s_cmp_lt_u32 s98, 1282
    s_cbranch_scc1 L_acc14
L_go14:
    global_load_dwordx4 v[208:211], v1, s[12:13] offset:0 nt
    global_load_dwordx4 v[212:215], v1, s[12:13] offset:128 nt
    global_load_dwordx4 v[216:219], v1, s[12:13] offset:256 nt
    s_add_u32 s12, s12, s29
    s_addc_u32 s13, s13, 0
    v_cvt_pk_bf16_f32 v96, v28, v28
    v_cvt_pk_bf16_f32 v97, v29, v29
    v_cvt_pk_bf16_f32 v98, v30, v30
    v_cvt_pk_bf16_f32 v99, v31, v31
    v_cvt_pk_bf16_f32 v100, v32, v32
    v_cvt_pk_bf16_f32 v101, v33, v33
    v_cvt_pk_bf16_f32 v102, v34, v34
    v_cvt_pk_bf16_f32 v103, v35, v35
    v_cvt_pk_bf16_f32 v104, v36, v36
    v_and_b32 v56, v96, v12
    v_and_b32 v57, v96, v13
    v_and_b32 v58, v96, v14
    v_and_b32 v59, v96, v15
    v_and_b32 v60, v97, v12
    v_and_b32 v61, v97, v13
    v_and_b32 v62, v97, v14
    v_and_b32 v63, v97, v15
    v_and_b32 v64, v98, v12
    v_and_b32 v65, v98, v13
    v_and_b32 v66, v98, v14
    v_and_b32 v67, v98, v15
    v_and_b32 v68, v99, v12
    v_and_b32 v69, v99, v13
    v_and_b32 v70, v99, v14
    v_and_b32 v71, v99, v15
    v_and_b32 v72, v100, v12
    v_and_b32 v73, v100, v13
    v_and_b32 v74, v100, v14
    v_and_b32 v75, v100, v15
    v_and_b32 v76, v101, v12
    v_and_b32 v77, v101, v13
    v_and_b32 v78, v101, v14
    v_and_b32 v79, v101, v15
    v_and_b32 v80, v102, v12
    v_and_b32 v81, v102, v13
    v_and_b32 v82, v102, v14
    v_and_b32 v83, v102, v15
    v_and_b32 v84, v103, v12
    v_and_b32 v85, v103, v13
    v_and_b32 v86, v103, v14
    v_and_b32 v87, v103, v15
    v_and_b32 v88, v104, v12
    v_and_b32 v89, v104, v13
    v_and_b32 v90, v104, v14
    v_and_b32 v91, v104, v15
    v_mov_b32 v11, v28
    v_add_f32 v11, v11, v29
    v_add_f32 v11, v11, v30
    v_add_f32 v11, v11, v31
    v_add_f32 v11, v11, v32
    v_add_f32 v11, v11, v33
    v_add_f32 v11, v11, v34
    v_add_f32 v11, v11, v35
    v_add_f32 v11, v11, v36
    s_nop 1
    v_add_f32_dpp v11, v11, v11 row_ror:8 row_mask:0xf bank_mask:0xf
    v_mov_b32 v96, v11
    s_nop 1
    v_permlane16_swap_b32 v11, v96
    v_add_f32 v11, v11, v96
    v_mov_b32 v96, v11
    s_nop 1
    v_permlane32_swap_b32 v11, v96
    v_add_f32 v11, v11, v96
    s_lshl_b32 s47, s26, 3
    v_mov_b32 v5, s47
    ds_write_b64 v5, v[10:11] offset:512
    s_mul_i32 s47, s26, 1568
    v_add_u32 v6, s47, v8
    v_and_b32 v118, 3, v0
    v_mul_u32_u24 v7, 3136, v118
    v_and_b32 v119, 60, v0
    v_lshl_add_u32 v7, v119, 2, v7
    s_lshl_b32 s47, s26, 8
    s_sub_u32 s47, s47, 1280
    v_add_u32 v7, s47, v7
    v_lshlrev_b32 v118, 4, v118
    s_lshl_b32 s47, s47, 1
    v_lshl_add_u32 v119, v119, 3, s47
    v_and_b32 v5, 16, v118
    v_add_u32 v119, v119, v5
    v_mul_u32_u24 v112, 1536, v2
    v_lshl_add_u32 v112, v3, 4, v112
    s_mov_b64 s[42:43], -1
    v_and_b32 v113, 1, v0
    v_cmp_ne_u32 s[40:41], 0, v113
    v_mov_b32 v113, s4
    v_mov_b32 v114, s5
    v_cndmask_b32 v113, v113, v114, s[40:41]
    v_and_b32 v114, 15, v0
    v_and_b32 v115, 16, v0
    v_lshl_add_u32 v114, v114, 5, v115
    s_lshl_b32 s47, s26, 9
    v_add_u32 v114, s47, v114
    s_lshl_b32 s47, s26, 6
    v_add_u32 v115, s47, v0
    v_and_b32 v126, -2, v115
    v_lshlrev_b32 v115, 2, v115
    v_lshrrev_b32 v116, 6, v115
    v_mul_u32_u24 v116, 192, v116
    v_add_u32 v115, v115, v116
    v_and_b32 v116, 1, v0
    v_lshlrev_b32 v116, 10, v116
    v_add_lshl_u32 v116, v116, v126, 1
    s_and_b32 s62, s4, 0x7fffc0
    s_add_u32 s62, s62, 1258291247
    v_mov_b32 v120, 0
    v_mov_b32 v121, 0
    v_mov_b32 v122, 0
    v_mov_b32 v123, 0
    s_waitcnt vmcnt(8)
L_acc15:
    s_memrealtime s[98:99]
    s_getreg_b32 s100, hwreg(HW_REG_IB_STS, 0, 4)
    s_cmp_le_u32 s100, 2
    s_cbranch_scc1 L_go15
    s_waitcnt lgkmcnt(0)
    s_sub_u32 s98, s98, s96
    s_cmp_lt_u32 s98, 1358
    s_cbranch_scc1 L_acc15
L_go15:
    global_load_dwordx4 v[220:223], v1, s[12:13] offset:0 nt
    global_load_dwordx4 v[224:227], v1, s[12:13] offset:128 nt
    global_load_dwordx4 v[228:231], v1, s[12:13] offset:256 nt
    s_add_u32 s12, s12, s29
    s_addc_u32 s13, s13, 0
    s_waitcnt vmcnt(8)
L_acc16:
    s_memrealtime s[98:99]
    s_getreg_b32 s100, hwreg(HW_REG_IB_STS, 0, 4)
    s_cmp_le_u32 s100, 2
    s_cbranch_scc1 L_go16
    s_waitcnt lgkmcnt(0)
    s_sub_u32 s98, s98, s96
    s_cmp_lt_u32 s98, 1434
    s_cbranch_scc1 L_acc16
L_go16:
    global_load_dwordx4 v[232:235], v1, s[12:13] offset:0 nt
    global_load_dwordx4 v[236:239], v1, s[12:13] offset:128 nt
    global_load_dwordx4 v[240:243], v1, s[12:13] offset:256 nt
    s_add_u32 s12, s12, s29
    s_addc_u32 s13, s13, 0
    s_waitcnt vmcnt(8)
L_acc17:
    s_memrealtime s[98:99]
    s_getreg_b32 s100, hwreg(HW_REG_IB_STS, 0, 4)
    s_cmp_le_u32 s100, 2
    s_cbranch_scc1 L_go17
    s_waitcnt lgkmcnt(0)
    s_sub_u32 s98, s98, s96
    s_cmp_lt_u32 s98, 1510
    s_cbranch_scc1 L_acc17
L_go17:
    global_load_dwordx4 v[244:247], v1, s[12:13] offset:0 nt
    global_load_dwordx4 v[248:251], v1, s[12:13] offset:128 nt
    global_load_dwordx4 v[252:255], v1, s[12:13] offset:256 nt
    s_nop 0
    s_barrier
    s_cmp_ge_u32 s28, 30
    s_cselect_b64 exec, 1, -1
    global_load_dwordx4 v[40:43], v9, s[60:61] offset:-3840 nt
    global_load_dwordx4 v[44:47], v9, s[60:61] offset:-1280 nt
    global_load_dwordx4 v[48:51], v9, s[60:61] offset:1280 nt
    global_load_dwordx4 v[52:55], v9, s[60:61] offset:3840 nt
    s_mov_b64 exec, -1
    s_waitcnt vmcnt(28)
    v_mfma_f32_16x16x32_bf16 v[16:19], v[56:59], v[148:151], v[16:19]
    v_mfma_f32_16x16x32_bf16 v[20:23], v[56:59], v[152:155], v[20:23]
    v_mfma_f32_16x16x32_bf16 v[24:27], v[56:59], v[156:159], v[24:27]
    s_waitcnt vmcnt(25)
    v_mfma_f32_16x16x32_bf16 v[16:19], v[60:63], v[160:163], v[16:19]
    v_mfma_f32_16x16x32_bf16 v[20:23], v[60:63], v[164:167], v[20:23]
    v_mfma_f32_16x16x32_bf16 v[24:27], v[60:63], v[168:171], v[24:27]
    s_waitcnt vmcnt(22)
    v_mfma_f32_16x16x32_bf16 v[16:19], v[64:67], v[172:175], v[16:19]
    v_mfma_f32_16x16x32_bf16 v[20:23], v[64:67], v[176:179], v[20:23]
    v_mfma_f32_16x16x32_bf16 v[24:27], v[64:67], v[180:183], v[24:27]
    s_waitcnt vmcnt(19)
    v_mfma_f32_16x16x32_bf16 v[16:19], v[68:71], v[184:187], v[16:19]
    v_mfma_f32_16x16x32_bf16 v[20:23], v[68:71], v[188:191], v[20:23]
    v_mfma_f32_16x16x32_bf16 v[24:27], v[68:71], v[192:195], v[24:27]
    s_waitcnt vmcnt(16)
    v_mfma_f32_16x16x32_bf16 v[16:19], v[72:75], v[196:199], v[16:19]
    v_mfma_f32_16x16x32_bf16 v[20:23], v[72:75], v[200:203], v[20:23]
    v_mfma_f32_16x16x32_bf16 v[24:27], v[72:75], v[204:207], v[24:27]
    s_waitcnt vmcnt(13)
    v_mfma_f32_16x16x32_bf16 v[16:19], v[76:79], v[208:211], v[16:19]
    v_mfma_f32_16x16x32_bf16 v[20:23], v[76:79], v[212:215], v[20:23]
    v_mfma_f32_16x16x32_bf16 v[24:27], v[76:79], v[216:219], v[24:27]
    s_waitcnt vmcnt(10)
    v_mfma_f32_16x16x32_bf16 v[16:19], v[80:83], v[220:223], v[16:19]
    v_mfma_f32_16x16x32_bf16 v[20:23], v[80:83], v[224:227], v[20:23]
    v_mfma_f32_16x16x32_bf16 v[24:27], v[80:83], v[228:231], v[24:27]
    s_waitcnt vmcnt(7)
    v_mfma_f32_16x16x32_bf16 v[16:19], v[84:87], v[232:235], v[16:19]
    v_mfma_f32_16x16x32_bf16 v[20:23], v[84:87], v[236:239], v[20:23]
    v_mfma_f32_16x16x32_bf16 v[24:27], v[84:87], v[240:243], v[24:27]
    s_waitcnt vmcnt(4)
    v_mfma_f32_16x16x32_bf16 v[16:19], v[88:91], v[244:247], v[16:19]
    v_mfma_f32_16x16x32_bf16 v[20:23], v[88:91], v[248:251], v[20:23]
    v_mfma_f32_16x16x32_bf16 v[24:27], v[88:91], v[252:255], v[24:27]
    s_branch L_tail
L_qcont:
    v_and_b32 v5, 1, v0
    v_lshlrev_b32 v5, 4, v5
    v_mov_b32 v6, 0xffff
    v_lshlrev_b32 v6, v5, v6
    v_lshrrev_b32 v5, 1, v3
    v_cmp_eq_u32 vcc, 0, v5
    s_nop 1
    v_cndmask_b32 v12, 0, v6, vcc
    v_cmp_eq_u32 vcc, 1, v5
    s_nop 1
    v_cndmask_b32 v13, 0, v6, vcc
    v_cmp_eq_u32 vcc, 2, v5
    s_nop 1
    v_cndmask_b32 v14, 0, v6, vcc
    v_cmp_eq_u32 vcc, 3, v5
    s_nop 1
    v_cndmask_b32 v15, 0, v6, vcc
    v_lshrrev_b32 v5, 5, v0
    v_mul_u32_u24 v8, 768, v5
    v_lshl_add_u32 v8, v3, 5, v8
    v_and_b32 v5, 16, v0
    v_add_u32 v8, v8, v5
    v_lshrrev_b32 v9, 5, v0
    v_lshrrev_b32 v5, 1, v5
    v_add_u32 v9, v9, v5
    v_mul_u32_u24 v9, 1280, v9
    v_and_b32 v5, 15, v0
    v_lshl_add_u32 v9, v5, 4, v9
    s_mul_i32 s50, s28, 13108
    s_lshr_b32 s50, s50, 16
    s_mul_i32 s51, s50, 5
    s_sub_u32 s51, s28, s51
    s_lshl3_add_u32 s52, s24, s25
    s_mul_i32 s53, s51, 4096
    s_lshl_b32 s47, s51, 8
    s_add_u32 s18, s18, s47
    s_addc_u32 s19, s19, 0
    s_add_u32 s53, s53, 1048576
    s_mul_i32 s47, s52, 1536
    s_add_u32 s47, s47, 524288
    s_add_u32 s54, s22, s47
    s_addc_u32 s55, s23, 0
    s_add_u32 s56, s22, s53
    s_addc_u32 s57, s23, 0
    s_mov_b32 s44, 16711935
    s_mov_b32 s45, 4278255360
    s_mul_i32 s58, s27, 768
    s_lshl_b32 s47, s50, 7
    s_add_u32 s58, s58, s47
    s_lshl_b32 s47, s26, 4
    s_add_u32 s58, s58, s47
    s_cmp_ge_u32 s28, 30
    s_cselect_b32 s58, 0, s58
    s_cselect_b32 s51, 0, s51
    s_lshr_b32 s47, s58, 6
    s_mul_i32 s59, s47, 43691
    s_lshr_b32 s59, s59, 17
    s_mul_i32 s47, s59, 192
    s_sub_u32 s58, s58, s47
    s_and_b32 s47, s59, 3
    s_lshr_b32 s46, s59, 2
    s_lshl3_add_u32 s47, s47, s46
    s_mul_i32 s47, s47, 192
    s_add_u32 s47, s47, s58
    s_mul_i32 s47, s47, 1280
    s_lshl_b32 s46, s51, 8
    s_add_u32 s47, s47, s46
    s_add_u32 s47, s47, 3840
    s_add_u32 s60, s16, s47
    s_addc_u32 s61, s17, 0
    s_mul_i32 s47, s59, 12288
    s_lshl_b32 s46, s58, 3
    s_add_u32 s47, s47, s46
    s_add_u32 s47, s47, 527360
    s_add_u32 s50, s22, s47
    s_addc_u32 s51, s23, 0
    s_mov_b32 s6, 1033096506
    s_mov_b32 s7, 1069066811
    s_waitcnt lgkmcnt(0)
    s_add_u32 s4, s4, 0x7f4a7c15
    s_addc_u32 s5, s5, 0x9e3779b9
    s_and_b32 s63, s4, 0x7fffc0
    s_or_b32 s63, s63, 0x4b000000
    s_cmp_ge_u32 s2, 10
    s_cbranch_scc1 L_noinit
    s_mul_i32 s47, s2, 2048
    s_add_u32 s47, s47, 1048576
    v_lshlrev_b32 v170, 4, v0
    v_lshrrev_b32 v171, 6, v170
    v_mul_u32_u24 v171, 192, v171
    v_add_u32 v170, v170, v171
    v_add_u32 v170, s47, v170
    v_mov_b32 v184, 0
    v_mov_b32 v185, s63
    v_mov_b32 v186, 0
    v_mov_b32 v187, s63
    s_mov_b32 exec_hi, 0
    global_store_dwordx4 v170, v[184:187], s[22:23] sc1
    s_mov_b32 exec_hi, -1
L_noinit:
    v_mov_b32 v16, 0
    v_mov_b32 v17, 0
    v_mov_b32 v18, 0
    v_mov_b32 v19, 0
    v_mov_b32 v20, 0
    v_mov_b32 v21, 0
    v_mov_b32 v22, 0
    v_mov_b32 v23, 0
    v_mov_b32 v24, 0
    v_mov_b32 v25, 0
    v_mov_b32 v26, 0
    v_mov_b32 v27, 0
    s_mov_b32 s47, 0x01000100
    s_mov_b32 s48, 0x03020302
    s_waitcnt vmcnt(33)
    v_perm_b32 v180, v28, v28, s47
    v_and_b32 v172, v180, v12
    v_and_b32 v173, v180, v13
    v_and_b32 v174, v180, v14
    v_and_b32 v175, v180, v15
    s_nop 1
    v_mfma_f32_16x16x32_bf16 v[16:19], v[172:175], v[40:43], v[16:19]
    v_mfma_f32_16x16x32_bf16 v[20:23], v[172:175], v[44:47], v[20:23]
    v_mfma_f32_16x16x32_bf16 v[24:27], v[172:175], v[48:51], v[24:27]
    s_waitcnt vmcnt(30)
    v_perm_b32 v180, v28, v28, s48
    v_and_b32 v176, v180, v12
    v_and_b32 v177, v180, v13
    v_and_b32 v178, v180, v14
    v_and_b32 v179, v180, v15
    s_nop 1
    v_mfma_f32_16x16x32_bf16 v[16:19], v[176:179], v[52:55], v[16:19]
    v_mfma_f32_16x16x32_bf16 v[20:23], v[176:179], v[56:59], v[20:23]
    v_mfma_f32_16x16x32_bf16 v[24:27], v[176:179], v[60:63], v[24:27]
    s_waitcnt vmcnt(27)
    v_perm_b32 v180, v29, v29, s47
    v_and_b32 v172, v180, v12
    v_and_b32 v173, v180, v13
    v_and_b32 v174, v180, v14
    v_and_b32 v175, v180, v15
    s_nop 1
    v_mfma_f32_16x16x32_bf16 v[16:19], v[172:175], v[64:67], v[16:19]
    v_mfma_f32_16x16x32_bf16 v[20:23], v[172:175], v[68:71], v[20:23]
    v_mfma_f32_16x16x32_bf16 v[24:27], v[172:175], v[72:75], v[24:27]
    s_waitcnt vmcnt(24)
    v_perm_b32 v180, v29, v29, s48
    v_and_b32 v176, v180, v12
    v_and_b32 v177, v180, v13
    v_and_b32 v178, v180, v14
    v_and_b32 v179, v180, v15
    s_nop 1
    v_mfma_f32_16x16x32_bf16 v[16:19], v[176:179], v[76:79], v[16:19]
    v_mfma_f32_16x16x32_bf16 v[20:23], v[176:179], v[80:83], v[20:23]
    v_mfma_f32_16x16x32_bf16 v[24:27], v[176:179], v[84:87], v[24:27]
    s_waitcnt vmcnt(21)
    v_perm_b32 v180, v30, v30, s47
    v_and_b32 v172, v180, v12
    v_and_b32 v173, v180, v13
    v_and_b32 v174, v180, v14
    v_and_b32 v175, v180, v15
    s_nop 1
    v_mfma_f32_16x16x32_bf16 v[16:19], v[172:175], v[88:91], v[16:19]
    v_mfma_f32_16x16x32_bf16 v[20:23], v[172:175], v[92:95], v[20:23]
    v_mfma_f32_16x16x32_bf16 v[24:27], v[172:175], v[96:99], v[24:27]
    s_waitcnt vmcnt(18)
    v_perm_b32 v180, v30, v30, s48
    v_and_b32 v176, v180, v12
    v_and_b32 v177, v180, v13
    v_and_b32 v178, v180, v14
    v_and_b32 v179, v180, v15
    s_nop 1
    v_mfma_f32_16x16x32_bf16 v[16:19], v[176:179], v[100:103], v[16:19]
    v_mfma_f32_16x16x32_bf16 v[20:23], v[176:179], v[104:107], v[20:23]
    v_mfma_f32_16x16x32_bf16 v[24:27], v[176:179], v[108:111], v[24:27]
    s_waitcnt vmcnt(15)
    v_perm_b32 v180, v31, v31, s47
    v_and_b32 v172, v180, v12
    v_and_b32 v173, v180, v13
    v_and_b32 v174, v180, v14
    v_and_b32 v175, v180, v15
    s_nop 1
    v_mfma_f32_16x16x32_bf16 v[16:19], v[172:175], v[112:115], v[16:19]
    v_mfma_f32_16x16x32_bf16 v[20:23], v[172:175], v[116:119], v[20:23]
    v_mfma_f32_16x16x32_bf16 v[24:27], v[172:175], v[120:123], v[24:27]
    s_waitcnt vmcnt(12)
    v_perm_b32 v180, v31, v31, s48
    v_and_b32 v176, v180, v12
    v_and_b32 v177, v180, v13
    v_and_b32 v178, v180, v14
    v_and_b32 v179, v180, v15
    s_nop 1
    v_mfma_f32_16x16x32_bf16 v[16:19], v[176:179], v[124:127], v[16:19]
    v_mfma_f32_16x16x32_bf16 v[20:23], v[176:179], v[128:131], v[20:23]
    v_mfma_f32_16x16x32_bf16 v[24:27], v[176:179], v[132:135], v[24:27]
    s_waitcnt vmcnt(9)
    v_perm_b32 v180, v32, v32, s47
    v_and_b32 v172, v180, v12
    v_and_b32 v173, v180, v13
    v_and_b32 v174, v180, v14
    v_and_b32 v175, v180, v15
    s_nop 1
    v_mfma_f32_16x16x32_bf16 v[16:19], v[172:175], v[136:139], v[16:19]
    v_mfma_f32_16x16x32_bf16 v[20:23], v[172:175], v[140:143], v[20:23]
    v_mfma_f32_16x16x32_bf16 v[24:27], v[172:175], v[144:147], v[24:27]
    s_waitcnt vmcnt(6)
    v_perm_b32 v180, v32, v32, s48
    v_and_b32 v176, v180, v12
    v_and_b32 v177, v180, v13
    v_and_b32 v178, v180, v14
    v_and_b32 v179, v180, v15
    s_nop 1
    v_mfma_f32_16x16x32_bf16 v[16:19], v[176:179], v[148:151], v[16:19]
    v_mfma_f32_16x16x32_bf16 v[20:23], v[176:179], v[152:155], v[20:23]
    v_mfma_f32_16x16x32_bf16 v[24:27], v[176:179], v[156:159], v[24:27]
    s_lshl_b32 s47, s52, 11
    s_add_u32 s47, s47, 1572864
    s_add_u32 s36, s22, s47
    s_addc_u32 s37, s23, 0
    s_getreg_b32 s48, hwreg(HW_REG_XCC_ID, 0, 4)
    v_mov_b32 v5, 13824
    v_lshl_add_u32 v5, v0, 3, v5
    v_lshlrev_b32 v6, 4, v0
    s_mov_b64 exec, s[44:45]
    ds_write_b128 v8, v[16:19] offset:13824
    ds_write_b128 v8, v[20:23] offset:14080
    ds_write_b128 v8, v[24:27] offset:14336
    s_mov_b64 exec, -1
    ds_read2_b64 v[72:75], v5 offset0:0 offset1:96
    ds_read2_b64 v[76:79], v5 offset0:64 offset1:160
    v_mov_b32 v66, s4
    v_mov_b32 v67, s5
    v_mov_b32 v70, s4
    v_mov_b32 v71, s5
    ds_write_b64 v4, v[66:67] offset:16
    v_cmp_gt_u32 vcc, 32, v0
    v_mov_b32 v80, s48
    s_waitcnt lgkmcnt(0)
    v_add_f32 v64, v72, v74
    v_add_f32 v65, v73, v75
    v_add_f32 v68, v76, v78
    v_add_f32 v69, v77, v79
    v_cndmask_b32 v68, v80, v68, vcc
    s_mov_b64 exec, -1
    global_store_dwordx4 v6, v[64:67], s[36:37]
    s_mov_b32 exec_hi, 0xff
    global_store_dwordx4 v6, v[68:71], s[36:37] offset:1024
    s_mov_b32 exec_hi, 0xffff
    s_add_u32 s42, s22, 1576960
    s_addc_u32 s43, s23, 0
    s_lshl_b32 s47, s24, 14
    v_lshl_add_u32 v160, v0, 4, s47
    v_add_u32 v161, 8192, v160
    v_and_b32 v163, 31, v0
    s_lshl_b32 s47, s27, 16
    v_lshl_add_u32 v162, v163, 11, s47
    v_and_b32 v163, 15, v0
    v_mul_u32_u24 v163, 256, v163
    s_mov_b32 s49, 262144
L_qpoll:
    global_load_dwordx4 v[88:91], v160, s[42:43] offset:-4096 sc1
    global_load_dwordx4 v[92:95], v160, s[42:43] offset:-3328 sc1
    global_load_dwordx4 v[96:99], v160, s[42:43] offset:-2048 sc1
    global_load_dwordx4 v[100:103], v160, s[42:43] offset:-1280 sc1
    global_load_dwordx4 v[104:107], v160, s[42:43] offset:0 sc1
    global_load_dwordx4 v[108:111], v160, s[42:43] offset:768 sc1
    global_load_dwordx4 v[112:115], v160, s[42:43] offset:2048 sc1
    global_load_dwordx4 v[116:119], v160, s[42:43] offset:2816 sc1
    global_load_dwordx4 v[120:123], v161, s[42:43] offset:-4096 sc1
    global_load_dwordx4 v[124:127], v161, s[42:43] offset:-3328 sc1
    global_load_dwordx4 v[128:131], v161, s[42:43] offset:-2048 sc1
    global_load_dwordx4 v[132:135], v161, s[42:43] offset:-1280 sc1
    global_load_dwordx4 v[136:139], v161, s[42:43] offset:0 sc1
    global_load_dwordx4 v[140:143], v161, s[42:43] offset:768 sc1
    global_load_dwordx4 v[144:147], v161, s[42:43] offset:2048 sc1
    global_load_dwordx4 v[148:151], v161, s[42:43] offset:2816 sc1
    global_load_dwordx4 v[188:191], v162, s[42:43] offset:-2560 sc1
    global_load_dwordx4 v[192:195], v163, s[56:57] sc1
    s_waitcnt vmcnt(0)
    v_cmp_ne_u64 vcc, s[4:5], v[190:191]
    v_cmp_ne_u64 s[46:47], s[4:5], v[90:91]
    s_or_b64 vcc, vcc, s[46:47]
    v_cmp_ne_u64 s[46:47], s[4:5], v[94:95]
    s_or_b64 vcc, vcc, s[46:47]
    v_cmp_ne_u64 s[46:47], s[4:5], v[98:99]
    s_or_b64 vcc, vcc, s[46:47]
    v_cmp_ne_u64 s[46:47], s[4:5], v[102:103]
    s_or_b64 vcc, vcc, s[46:47]
    v_cmp_ne_u64 s[46:47], s[4:5], v[106:107]
    s_or_b64 vcc, vcc, s[46:47]
    v_cmp_ne_u64 s[46:47], s[4:5], v[110:111]
    s_or_b64 vcc, vcc, s[46:47]
    v_cmp_ne_u64 s[46:47], s[4:5], v[114:115]
    s_or_b64 vcc, vcc, s[46:47]
    v_cmp_ne_u64 s[46:47], s[4:5], v[118:119]
    s_or_b64 vcc, vcc, s[46:47]
    v_cmp_ne_u64 s[46:47], s[4:5], v[122:123]
    s_or_b64 vcc, vcc, s[46:47]
    v_cmp_ne_u64 s[46:47], s[4:5], v[126:127]
    s_or_b64 vcc, vcc, s[46:47]
    v_cmp_ne_u64 s[46:47], s[4:5], v[130:131]
    s_or_b64 vcc, vcc, s[46:47]
    v_cmp_ne_u64 s[46:47], s[4:5], v[134:135]
    s_or_b64 vcc, vcc, s[46:47]
    v_cmp_ne_u64 s[46:47], s[4:5], v[138:139]
    s_or_b64 vcc, vcc, s[46:47]
    v_cmp_ne_u64 s[46:47], s[4:5], v[142:143]
    s_or_b64 vcc, vcc, s[46:47]
    v_cmp_ne_u64 s[46:47], s[4:5], v[146:147]
    s_or_b64 vcc, vcc, s[46:47]
    v_cmp_ne_u64 s[46:47], s[4:5], v[150:151]
    s_or_b64 vcc, vcc, s[46:47]
    v_subrev_u32 v193, s63, v193
    v_subrev_u32 v195, s63, v195
    v_max_u32 v193, v193, v195
    v_cmp_lt_u32 s[46:47], 47, v193
    s_or_b64 vcc, vcc, s[46:47]
    s_cbranch_scc0 L_qpoll_done
    s_cmp_lg_u32 s49, 262132
    s_cbranch_scc1 L_qagain
    s_mov_b64 exec, -1
    global_store_dwordx4 v6, v[64:67], s[36:37] sc1
    s_mov_b32 exec_hi, 0xff
    global_store_dwordx4 v6, v[68:71], s[36:37] offset:1024 sc1
    s_mov_b32 exec_hi, 0xffff
L_qagain:
    s_sleep 8
    s_sub_u32 s49, s49, 1
    s_cbranch_scc0 L_qpoll
    s_branch L_end
L_qpoll_done:
    v_cmp_ne_u32 vcc, s48, v188
    s_mov_b32 s47, 1
    s_cmp_eq_u64 vcc, 0
    s_cbranch_scc1 L_xok
    s_mov_b64 exec, -1
    global_store_dwordx4 v6, v[64:67], s[36:37] sc1
    s_mov_b32 exec_hi, 0xff
    global_store_dwordx4 v6, v[68:71], s[36:37] offset:1024 sc1
    s_mov_b32 exec_hi, 0xffff
    s_mov_b32 s47, 0
L_xok:
    v_mov_b32 v184, s47
    ds_write_b32 v4, v184 offset:64
    v_add_f32 v88, v88, v120
    v_add_f32 v89, v89, v121
    v_add_f32 v92, v92, v124
    v_add_f32 v93, v93, v125
    v_add_f32 v96, v96, v128
    v_add_f32 v97, v97, v129
    v_add_f32 v100, v100, v132
    v_add_f32 v101, v101, v133
    v_add_f32 v104, v104, v136
    v_add_f32 v105, v105, v137
    v_add_f32 v108, v108, v140
    v_add_f32 v109, v109, v141
    v_add_f32 v112, v112, v144
    v_add_f32 v113, v113, v145
    v_add_f32 v116, v116, v148
    v_add_f32 v117, v117, v149
    v_add_f32 v88, v88, v104
    v_add_f32 v89, v89, v105
    v_add_f32 v92, v92, v108
    v_add_f32 v93, v93, v109
    v_add_f32 v96, v96, v112
    v_add_f32 v97, v97, v113
    v_add_f32 v100, v100, v116
    v_add_f32 v101, v101, v117
    v_add_f32 v88, v88, v96
    v_add_f32 v89, v89, v97
    v_add_f32 v92, v92, v100
    v_add_f32 v93, v93, v101
    v_cvt_pk_bf16_f32 v180, v88, v89
    v_cvt_pk_bf16_f32 v181, v92, v93
    v_lshlrev_b32 v5, 2, v0
    ds_write2_b32 v5, v180, v181 offset0:32 offset1:80
    s_mov_b64 exec, -1
    s_waitcnt lgkmcnt(0)
    v_mov_b32 v184, 1
    ds_write_b32 v4, v184 offset:0
    s_setprio 0
    v_lshlrev_b32 v5, 4, v3
    ds_read_b128 v[16:19], v5 offset:128
    ds_read_b128 v[20:23], v5 offset:256
    ds_read_b128 v[24:27], v5 offset:384
    s_waitcnt lgkmcnt(0)
    v_dot2_f32_bf16 v28, v232, v16, 0
    v_dot2_f32_bf16 v28, v233, v17, v28
    v_dot2_f32_bf16 v28, v234, v18, v28
    v_dot2_f32_bf16 v28, v235, v19, v28
    v_dot2_f32_bf16 v28, v236, v20, v28
    v_dot2_f32_bf16 v28, v237, v21, v28
    v_dot2_f32_bf16 v28, v238, v22, v28
    v_dot2_f32_bf16 v28, v239, v23, v28
    v_dot2_f32_bf16 v28, v240, v24, v28
    v_dot2_f32_bf16 v28, v241, v25, v28
    v_dot2_f32_bf16 v28, v242, v26, v28
    v_dot2_f32_bf16 v28, v243, v27, v28
    v_mov_b32 v16, 0
    v_mov_b32 v17, 0
    v_mov_b32 v18, 0
    v_mov_b32 v19, 0
    v_mov_b32 v20, 0
    v_mov_b32 v21, 0
    v_mov_b32 v22, 0
    v_mov_b32 v23, 0
    v_mov_b32 v24, 0
    v_mov_b32 v25, 0
    v_mov_b32 v26, 0
    v_mov_b32 v27, 0
    s_nop 1
    v_add_f32_dpp v28, v28, v28 quad_perm:[1,0,3,2] row_mask:0xf bank_mask:0xf
    s_nop 1
    v_add_f32_dpp v28, v28, v28 quad_perm:[2,3,0,1] row_mask:0xf bank_mask:0xf
    s_nop 1
    v_add_f32_dpp v28, v28, v28 row_half_mirror row_mask:0xf bank_mask:0xf
    v_cvt_pk_bf16_f32 v96, v28, v28
    v_lshlrev_b32 v28, 16, v96
    v_mul_f32 v28, s6, v28
    v_cvt_pk_bf16_f32 v96, v28, v28
    v_lshlrev_b32 v28, 16, v96
    v_mov_b32 v10, v28
    s_nop 1
    v_max_f32_dpp v10, v10, v10 row_ror:8 row_mask:0xf bank_mask:0xf
    v_mov_b32 v96, v10
    s_nop 1
    v_permlane16_swap_b32 v10, v96
    v_max_f32 v10, v10, v96
    v_mov_b32 v96, v10
    s_nop 1
    v_permlane32_swap_b32 v10, v96
    v_max_f32 v10, v10, v96
    s_mov_b32 s47, 1101004800
    v_cmp_lt_f32 vcc, s47, |v10|
    s_nop 1
    v_cndmask_b32 v10, 0, v10, vcc
    v_sub_f32 v28, v28, v10
    v_mul_f32 v28, s7, v28
    v_exp_f32 v28, v28
    s_nop 0
    v_cvt_pk_bf16_f32 v96, v28, v28
    v_and_b32 v56, v96, v12
    v_and_b32 v57, v96, v13
    v_and_b32 v58, v96, v14
    v_and_b32 v59, v96, v15
    v_mov_b32 v11, v28
    s_nop 1
    v_add_f32_dpp v11, v11, v11 row_ror:8 row_mask:0xf bank_mask:0xf
    v_mov_b32 v96, v11
    s_nop 1
    v_permlane16_swap_b32 v11, v96
    v_add_f32 v11, v11, v96
    v_mov_b32 v96, v11
    s_nop 1
    v_permlane32_swap_b32 v11, v96
    v_add_f32 v11, v11, v96
    s_lshl_b32 s47, s26, 3
    v_mov_b32 v5, s47
    ds_write_b64 v5, v[10:11] offset:512
    s_mul_i32 s47, s26, 1568
    v_add_u32 v6, s47, v8
    v_and_b32 v118, 3, v0
    v_mul_u32_u24 v7, 3136, v118
    v_and_b32 v119, 60, v0
    v_lshl_add_u32 v7, v119, 2, v7
    s_lshl_b32 s47, s26, 8
    s_sub_u32 s47, s47, 1280
    v_add_u32 v7, s47, v7
    v_lshlrev_b32 v118, 4, v118
    s_lshl_b32 s47, s47, 1
    v_lshl_add_u32 v119, v119, 3, s47
    v_and_b32 v5, 16, v118
    v_add_u32 v119, v119, v5
    v_mul_u32_u24 v112, 1536, v2
    v_lshl_add_u32 v112, v3, 4, v112
    s_mov_b64 s[42:43], -1
    v_and_b32 v113, 1, v0
    v_cmp_ne_u32 s[40:41], 0, v113
    v_mov_b32 v113, s4
    v_mov_b32 v114, s5
    v_cndmask_b32 v113, v113, v114, s[40:41]
    v_and_b32 v114, 15, v0
    v_and_b32 v115, 16, v0
    v_lshl_add_u32 v114, v114, 5, v115
    s_lshl_b32 s47, s26, 9
    v_add_u32 v114, s47, v114
    s_lshl_b32 s47, s26, 6
    v_add_u32 v115, s47, v0
    v_and_b32 v126, -2, v115
    v_lshlrev_b32 v115, 2, v115
    v_lshrrev_b32 v116, 6, v115
    v_mul_u32_u24 v116, 192, v116
    v_add_u32 v115, v115, v116
    v_and_b32 v116, 1, v0
    v_lshlrev_b32 v116, 10, v116
    v_add_lshl_u32 v116, v116, v126, 1
    s_and_b32 s62, s4, 0x7fffc0
    s_add_u32 s62, s62, 1258291247
    v_mov_b32 v120, 0
    v_mov_b32 v121, 0
    v_mov_b32 v122, 0
    v_mov_b32 v123, 0
    v_mfma_f32_16x16x32_bf16 v[16:19], v[56:59], v[244:247], v[16:19]
    v_mfma_f32_16x16x32_bf16 v[20:23], v[56:59], v[248:251], v[20:23]
    v_mfma_f32_16x16x32_bf16 v[24:27], v[56:59], v[252:255], v[24:27]
L_qwo:
    s_barrier
    s_cmp_ge_u32 s28, 30
    s_cselect_b64 exec, 1, -1
    global_load_dwordx4 v[40:43], v9, s[60:61] offset:-3840 nt
    global_load_dwordx4 v[44:47], v9, s[60:61] offset:-1280 nt
    global_load_dwordx4 v[48:51], v9, s[60:61] offset:1280 nt
    global_load_dwordx4 v[52:55], v9, s[60:61] offset:3840 nt
    s_mov_b64 exec, -1
L_tail:
    s_mov_b64 exec, s[44:45]
    s_nop 6
    ds_write_b128 v6, v[16:19] offset:1024
    ds_write_b128 v6, v[20:23] offset:1280
    ds_write_b128 v6, v[24:27] offset:1536
    s_mov_b64 exec, -1
    s_waitcnt lgkmcnt(0)
L_tail2:
    s_barrier
    s_cmp_lt_u32 s26, 5
    s_cbranch_scc1 L_nocomb
    ds_read_b128 v[164:167], v118 offset:512
    ds_read_b32 v172, v4 offset:64
    ds_read_b128 v[148:151], v7 offset:1024
    ds_read_b128 v[152:155], v7 offset:1792
    ds_read_b128 v[156:159], v7 offset:2592
    ds_read_b128 v[160:163], v7 offset:3360
    v_and_b32 v6, 1, v0
    v_cmp_eq_u32 vcc, 1, v6
    v_mov_b32 v170, s4
    v_mov_b32 v171, s5
    s_waitcnt lgkmcnt(4)
    v_max_f32 v168, v164, v166
    v_readfirstlane_b32 s46, v172
    v_cndmask_b32 v170, v170, v171, vcc
    v_max_f32_dpp v168, v168, v168 quad_perm:[1,0,3,2] row_mask:0xf bank_mask:0xf
    s_nop 1
    v_max_f32_dpp v168, v168, v168 quad_perm:[2,3,0,1] row_mask:0xf bank_mask:0xf
    v_sub_f32 v164, v164, v168
    v_sub_f32 v166, v166, v168
    v_mul_f32 v164, s7, v164
    v_mul_f32 v166, s7, v166
    v_exp_f32 v164, v164
    v_exp_f32 v166, v166
    v_cmp_neq_f32 s[36:37], 0, v168
    v_xor_b32 v171, 1, v170
    s_orn2_b64 s[38:39], vcc, s[36:37]
    v_cndmask_b32 v170, v170, v171, s[36:37]
    s_waitcnt lgkmcnt(0)
    v_add_f32 v148, v148, v152
    v_add_f32 v149, v149, v153
    v_add_f32 v150, v150, v154
    v_add_f32 v151, v151, v155
    v_add_f32 v156, v156, v160
    v_add_f32 v157, v157, v161
    v_add_f32 v158, v158, v162
    v_add_f32 v159, v159, v163
    v_mul_f32 v169, v164, v165
    v_mul_f32 v148, v148, v164
    v_mul_f32 v149, v149, v164
    v_mul_f32 v150, v150, v164
    v_mul_f32 v151, v151, v164
    v_fmac_f32 v169, v166, v167
    v_fmac_f32 v148, v156, v166
    v_fmac_f32 v149, v157, v166
    v_fmac_f32 v150, v158, v166
    v_fmac_f32 v151, v159, v166
    v_add_f32_dpp v169, v169, v169 quad_perm:[1,0,3,2] row_mask:0xf bank_mask:0xf
    v_add_f32_dpp v148, v148, v148 quad_perm:[1,0,3,2] row_mask:0xf bank_mask:0xf
    v_add_f32_dpp v149, v149, v149 quad_perm:[1,0,3,2] row_mask:0xf bank_mask:0xf
    v_add_f32_dpp v150, v150, v150 quad_perm:[1,0,3,2] row_mask:0xf bank_mask:0xf
    v_add_f32_dpp v151, v151, v151 quad_perm:[1,0,3,2] row_mask:0xf bank_mask:0xf
    v_add_f32_dpp v169, v169, v169 quad_perm:[2,3,0,1] row_mask:0xf bank_mask:0xf
    v_add_f32_dpp v148, v148, v148 quad_perm:[2,3,0,1] row_mask:0xf bank_mask:0xf
    v_add_f32_dpp v149, v149, v149 quad_perm:[2,3,0,1] row_mask:0xf bank_mask:0xf
    v_add_f32_dpp v150, v150, v150 quad_perm:[2,3,0,1] row_mask:0xf bank_mask:0xf
    v_add_f32_dpp v151, v151, v151 quad_perm:[2,3,0,1] row_mask:0xf bank_mask:0xf
    v_cndmask_b32 v148, v148, v150, vcc
    v_cndmask_b32 v149, v149, v151, vcc
    v_cndmask_b32 v150, v168, v169, s[38:39]
    v_mov_b32 v151, v170
    s_mov_b32 exec_lo, 0x33333333
    s_mov_b32 exec_hi, 0x33333333
    s_cmp_eq_u32 s46, 1
    s_cbranch_scc1 L_recloc
    global_store_dwordx4 v119, v[148:151], s[54:55] sc1
    s_branch L_recdone
L_recloc:
    global_store_dwordx4 v119, v[148:151], s[54:55]
L_recdone:
    s_mov_b64 exec, -1
L_nocomb:
    s_barrier
    s_mov_b32 s49, 262144
    s_cmp_ge_u32 s28, 30
    s_cbranch_scc0 L_h1poll
    s_branch L_fin
L_h1miss:
    v_xor_b32 v196, v113, v183
    v_cmp_lt_u32 vcc, 1, v196
    s_sleep 1
    s_cmp_eq_u64 vcc, 0
    s_cbranch_scc1 L_h1slow
    s_sub_u32 s49, s49, 1
    s_cbranch_scc1 L_end
    s_mov_b64 exec, vcc
L_h1poll:
    global_load_dwordx4 v[180:183], v112, s[50:51] offset:-3072 sc1
    s_mov_b64 exec, -1
L_h1chk:
    s_waitcnt vmcnt(0)
    v_cmp_ne_u32 vcc, v113, v183
    v_add_f32_dpp v194, v182, v182 row_ror:8 row_mask:0xf bank_mask:0xf
    s_cbranch_vccnz L_h1miss
L_h1done:
    v_permlane32_swap_b32 v180, v181
    v_add_f32 v196, v180, v181
    v_add_f32_dpp v194, v194, v194 row_bcast:15 row_mask:0xa bank_mask:0xf
    s_nop 0
    v_mov_b32_dpp v197, v196 row_ror:4 row_mask:0xf bank_mask:0xf
    v_add_f32_dpp v194, v194, v194 row_bcast:31 row_mask:0xc bank_mask:0xf
    s_nop 0
    v_permlane16_swap_b32 v196, v197
    v_readlane_b32 s47, v194, 63
    v_add_f32 v196, v196, v197
    s_nop 0
    v_rcp_f32 v194, s47
    v_add_f32_dpp v196, v196, v196 row_ror:8 row_mask:0xf bank_mask:0xf
    v_mul_f32 v196, v196, v194
    v_cvt_pk_bf16_f32 v196, v196, v196
    s_nop 1
    v_and_b32_dpp v56, v196, v12 row_newbcast:0 row_mask:0xf bank_mask:0xf
    v_and_b32_dpp v57, v196, v13 row_newbcast:0 row_mask:0xf bank_mask:0xf
    v_and_b32_dpp v58, v196, v14 row_newbcast:0 row_mask:0xf bank_mask:0xf
    v_and_b32_dpp v59, v196, v15 row_newbcast:0 row_mask:0xf bank_mask:0xf
    v_and_b32_dpp v60, v196, v12 row_newbcast:1 row_mask:0xf bank_mask:0xf
    v_and_b32_dpp v61, v196, v13 row_newbcast:1 row_mask:0xf bank_mask:0xf
    v_mfma_f32_16x16x32_bf16 v[120:123], v[56:59], v[40:43], v[120:123]
    v_and_b32_dpp v62, v196, v14 row_newbcast:1 row_mask:0xf bank_mask:0xf
    v_and_b32_dpp v63, v196, v15 row_newbcast:1 row_mask:0xf bank_mask:0xf
    v_and_b32_dpp v64, v196, v12 row_newbcast:2 row_mask:0xf bank_mask:0xf
    v_and_b32_dpp v65, v196, v13 row_newbcast:2 row_mask:0xf bank_mask:0xf
    v_mfma_f32_16x16x32_bf16 v[120:123], v[60:63], v[44:47], v[120:123]
    v_and_b32_dpp v66, v196, v14 row_newbcast:2 row_mask:0xf bank_mask:0xf
    v_and_b32_dpp v67, v196, v15 row_newbcast:2 row_mask:0xf bank_mask:0xf
    v_and_b32_dpp v68, v196, v12 row_newbcast:3 row_mask:0xf bank_mask:0xf
    v_and_b32_dpp v69, v196, v13 row_newbcast:3 row_mask:0xf bank_mask:0xf
    v_mfma_f32_16x16x32_bf16 v[120:123], v[64:67], v[48:51], v[120:123]
    v_and_b32_dpp v70, v196, v14 row_newbcast:3 row_mask:0xf bank_mask:0xf
    v_and_b32_dpp v71, v196, v15 row_newbcast:3 row_mask:0xf bank_mask:0xf
    s_nop 1
    v_mfma_f32_16x16x32_bf16 v[120:123], v[68:71], v[52:55], v[120:123]
    s_mov_b32 exec_hi, 0
    s_nop 6
    ds_write_b128 v114, v[120:123] offset:13824
    s_mov_b32 exec_hi, -1
    s_cmp_ge_u32 s26, 4
    s_waitcnt lgkmcnt(0)
    s_barrier
    s_cbranch_scc1 L_fin
    ds_read2st64_b32 v[204:205], v116 offset0:54 offset1:56
    ds_read2st64_b32 v[206:207], v116 offset0:58 offset1:60
    s_cmp_eq_u32 s53, 1048576
    s_cselect_b32 s38, s26, 1
    v_mov_b32 v210, s4
    v_mov_b32 v211, s5
    s_waitcnt lgkmcnt(0)
    v_pk_add_f32 v[204:205], v[204:205], v[206:207]
    v_add_f32 v204, v204, v205
    s_nop 1
    v_add_f32_dpp v204, v204, v204 quad_perm:[1,0,3,2] row_mask:0xf bank_mask:0xf
    v_cndmask_b32 v204, v204, 1.0, s[40:41]
    global_atomic_add_f32 v206, v115, v204, s[56:57] sc0 sc1
    s_waitcnt vmcnt(0)
    v_cmp_eq_u32 vcc, s62, v206
    v_add_f32 v206, v206, v204
    s_and_b64 vcc, vcc, s[40:41]
    s_lshr_b64 exec, vcc, 1
    s_cbranch_scc0 L_fin
    v_cvt_pk_bf16_f32 v206, v206, v206
    global_store_short v126, v206, s[18:19]
    s_cmp_lg_u32 s38, 0
    s_cbranch_scc1 L_fin
    s_and_b64 exec, exec, 1
    s_cbranch_scc0 L_fin
    global_store_dwordx2 v4, v[210:211], s[22:23] offset:0
L_fin:
L_end:
    s_endpgm
L_h1slow:
    s_mov_b64 exec, -1
    ds_swizzle_b32 v200, v182 offset:1055
    s_waitcnt lgkmcnt(0)
    v_cndmask_b32 v196, v182, v200, s[40:41]
    v_cndmask_b32 v198, v200, v182, s[40:41]
    v_cmp_ne_u32 vcc, v113, v183
    s_nop 1
    v_cndmask_b32 v196, 0, v196, vcc
    v_mov_b32 v200, v196
    s_nop 1
    v_max_f32_dpp v200, v200, v200 row_ror:8 row_mask:0xf bank_mask:0xf
    v_mov_b32 v201, v200
    s_nop 1
    v_permlane16_swap_b32 v200, v201
    v_max_f32 v200, v200, v201
    v_mov_b32 v201, v200
    s_nop 1
    v_permlane32_swap_b32 v200, v201
    v_max_f32 v200, v200, v201
    v_sub_f32 v196, v196, v200
    v_mul_f32 v196, s7, v196
    v_exp_f32 v196, v196
    s_nop 0
    v_mul_f32 v198, v198, v196
    v_mul_f32 v180, v180, v196
    v_mul_f32 v181, v181, v196
    v_add_f32_dpp v194, v198, v198 row_ror:8 row_mask:0xf bank_mask:0xf
    s_nop 1
    s_branch L_h1done
    s_endpgm
.section .rodata,"a"
.p2align 6
.amdhsa_kernel standalone__sliding_block_cached__decode_kernel
  .amdhsa_next_free_vgpr 256
  .amdhsa_next_free_sgpr 102
  .amdhsa_accum_offset 256
  .amdhsa_group_segment_fixed_size 0
  .amdhsa_kernarg_size 64
  .amdhsa_user_sgpr_count 2
  .amdhsa_user_sgpr_kernarg_segment_ptr 1
  .amdhsa_system_sgpr_workgroup_id_x 1
.end_amdhsa_kernel
```
